```python
import torch

def _softmax(x, axis=-1):
    return torch.softmax(x, dim=axis)

def _gelu(x):
    return torch.nn.functional.gelu(x, approximate='tanh')

def _silu(x):
    return torch.nn.functional.silu(x)

def _sigmoid(x):
    return torch.sigmoid(x)

def _layernorm(x, axis=-1, eps=1e-05):
    m = x.mean(dim=axis, keepdim=True)
    v = x.var(dim=axis, keepdim=True, unbiased=False)
    return (x - m) / torch.sqrt(v + eps)

def _scatter_add(tgt, idx, src, axis=0):
    return tgt.clone().index_add_(axis, idx, src)

def _segment_sum(src, seg, n):
    out = torch.zeros((n,) + src.shape[1:], dtype=src.dtype)
    return out.index_add_(0, seg, src)

def _pad(x, pw):
    flat = tuple((v for pair in reversed(pw) for v in pair))
    return torch.nn.functional.pad(x, flat)
kernel_name = 'standalone__tree_speculative_verify_tree_attention_over_candidate_token_tree__decode'

def setup_inputs():

    _w = lambda a: (lambda t: t.to(torch.bfloat16) if t.is_floating_point() else t)(torch.as_tensor(a))
    B, Hq, Hkv, T, C, D = (1, 32, 32, 1, 8192, 192)
    tree_mask = torch.zeros((B, T, T), dtype=float)
    for b in range(B):
        parent = torch.zeros(T, dtype=torch.int64)
        for i in range(1, T):
            parent[i] = int(torch.randint(0, i, (1,)).item())
        for i in range(T):
            j = i
            tree_mask[b, i, j] = 1.0
            while j > 0:
                j = parent[j]
                tree_mask[b, i, j] = 1.0
    return {'q': _w((lambda *s: torch.randn(*s, dtype=torch.bfloat16) * 0.8)(B, Hq, T, D)), 'k_cache': _w((lambda *s: torch.randn(*s, dtype=torch.bfloat16) * 0.8)(B, Hkv, C, D)), 'v_cache': _w((lambda *s: torch.randn(*s, dtype=torch.bfloat16) * 0.05)(B, Hkv, C, D)), 'k_tree': _w((lambda *s: torch.randn(*s, dtype=torch.bfloat16) * 0.8)(B, Hkv, T, D)), 'v_tree': _w((lambda *s: torch.randn(*s, dtype=torch.bfloat16) * 0.05)(B, Hkv, T, D)), 'tree_mask': _w(tree_mask)}

def reference(q, k_cache, v_cache, k_tree, v_tree, tree_mask):
    B, Hq, T, D = q.shape
    Hkv, C = (k_cache.shape[1], k_cache.shape[2])
    rep = Hq // Hkv
    kc = (lambda x, n, axis: torch.repeat_interleave(x, n, dim=axis))(k_cache, rep, axis=1)
    vc = (lambda x, n, axis: torch.repeat_interleave(x, n, dim=axis))(v_cache, rep, axis=1)
    kt = (lambda x, n, axis: torch.repeat_interleave(x, n, dim=axis))(k_tree, rep, axis=1)
    vt = (lambda x, n, axis: torch.repeat_interleave(x, n, dim=axis))(v_tree, rep, axis=1)
    k = torch.concatenate([kc, kt], axis=2)
    v = torch.concatenate([vc, vt], axis=2)
    scale = D ** (-0.5)
    scores = torch.einsum('bhqd,bhkd->bhqk', q, k) * scale
    ctx_mask = torch.ones((B, 1, T, C), dtype=scores.dtype)
    tm = tree_mask[:, None, :, :].clone()
    full_mask = torch.concatenate([ctx_mask, tm], axis=-1)
    scores = scores + (1.0 - full_mask) * -1000000000.0
    p = _softmax(scores, axis=-1)
    return torch.einsum('bhqk,bhkd->bhqd', p, v)
```

```asm
; @launch grid=(256,1,1) block=(128,1,1) lds=100000
.amdgcn_target "amdgcn-amd-amdhsa--gfx950"
.text
.globl standalone__tree_speculative_verify_tree_attention_over_candidate_token_tree__decode_kernel
.p2align 8
.type standalone__tree_speculative_verify_tree_attention_over_candidate_token_tree__decode_kernel,@function
standalone__tree_speculative_verify_tree_attention_over_candidate_token_tree__decode_kernel:
    s_cmp_ge_u32 s2, 256
    s_cbranch_scc1 L_end
    s_load_dwordx16 s[16:31], s[0:1], 0
    s_load_dwordx2 s[32:33], s[0:1], 64
    v_lshrrev_b32 v3, 6, v0
    v_and_b32 v0, 63, v0
    v_readfirstlane_b32 s4, v3
    s_and_b32 s5, s2, 7
    s_lshr_b32 s6, s2, 3
    s_mul_i32 s5, s5, 32
    s_add_u32 s2, s5, s6
    s_lshr_b32 s5, s2, 3
    s_and_b32 s6, s2, 7
    v_lshrrev_b32 v4, 3, v0
    v_and_b32 v5, 7, v0
    v_lshlrev_b32 v6, 4, v5
    s_movk_i32 s7, 384
    v_mad_u32_u24 v1, v4, s7, v6
    s_mul_i32 s8, s2, 393216
    s_mul_i32 s9, s4, 0
    s_add_u32 s8, s8, s9
    v_add_u32 v1, s8, v1
    s_mul_i32 s9, s5, 384
    v_add_u32 v7, s9, v6
    s_mov_b32 s38, 100663296
    s_mov_b32 s39, 0x20000
    s_mov_b32 s42, 100663296
    s_mov_b32 s43, 0x20000
    s_mov_b32 s46, 12288
    s_mov_b32 s47, 0x20000
    s_mov_b32 s50, 12288
    s_mov_b32 s51, 0x20000
    s_mov_b32 s54, 12288
    s_mov_b32 s55, 0x20000
    s_mov_b32 s58, 2
    s_mov_b32 s59, 0x20000
    s_mul_i32 s60, s4, 3072
    s_add_u32 s60, s60, 0
    s_mul_i32 s61, s4, 3072
    s_add_u32 s61, s61, 6144
    s_mul_i32 s62, s4, 3072
    s_add_u32 s62, s62, 12288
    s_mov_b32 s13, 3
    s_mov_b32 s14, 18432
    s_mov_b32 s10, 0x3dd53b95
    v_mov_b32 v8, 1152
    v_mov_b32 v6, 6
    ds_write_b32 v8, v6
    s_waitcnt lgkmcnt(0)
    s_barrier
    s_mov_b32 s44, s16
    s_mov_b32 s45, s17
    s_mov_b32 s36, s18
    s_mov_b32 s37, s19
    s_mov_b32 s40, s20
    s_mov_b32 s41, s21
    buffer_load_dwordx4 v[12:15], v7, s[44:47], 0 offen offset:0
    buffer_load_dwordx4 v[16:19], v7, s[44:47], 0 offen offset:128
    buffer_load_dwordx4 v[20:23], v7, s[44:47], 0 offen offset:256
    s_or_b32 s15, s4, s6
    s_cmp_lg_u32 s15, 0
    s_cbranch_scc1 L_notree0
    s_mov_b32 s48, s22
    s_mov_b32 s49, s23
    s_mov_b32 s52, s24
    s_mov_b32 s53, s25
    s_mov_b32 s56, s26
    s_mov_b32 s57, s27
    buffer_load_dwordx4 v[52:55], v7, s[48:51], 0 offen offset:0
    buffer_load_dwordx4 v[56:59], v7, s[48:51], 0 offen offset:128
    buffer_load_dwordx4 v[60:63], v7, s[48:51], 0 offen offset:256
    v_bfe_u32 v8, v0, 4, 1
    v_lshl_add_u32 v8, v8, 3, v7
    buffer_load_dwordx2 v[40:41], v8, s[52:55], 0 offen offset:0
    buffer_load_dwordx2 v[42:43], v8, s[52:55], 0 offen offset:128
    buffer_load_dwordx2 v[44:45], v8, s[52:55], 0 offen offset:256
    v_mov_b32 v8, 0
    buffer_load_ushort v9, v8, s[56:59], 0 offen
L_notree0:
    buffer_load_dwordx4 v[64:67], v1, s[36:39], s60 offen offset:0 nt
    buffer_load_dwordx4 v[68:71], v1, s[36:39], s60 offen offset:128 nt
    buffer_load_dwordx4 v[72:75], v1, s[36:39], s60 offen offset:256 nt
    buffer_load_dwordx4 v[76:79], v1, s[40:43], s60 offen offset:0 nt
    buffer_load_dwordx4 v[80:83], v1, s[40:43], s60 offen offset:128 nt
    buffer_load_dwordx4 v[84:87], v1, s[40:43], s60 offen offset:256 nt
    buffer_load_dwordx4 v[88:91], v1, s[36:39], s61 offen offset:0 nt
    buffer_load_dwordx4 v[92:95], v1, s[36:39], s61 offen offset:128 nt
    buffer_load_dwordx4 v[96:99], v1, s[36:39], s61 offen offset:256 nt
    buffer_load_dwordx4 v[100:103], v1, s[40:43], s61 offen offset:0 nt
    buffer_load_dwordx4 v[104:107], v1, s[40:43], s61 offen offset:128 nt
    buffer_load_dwordx4 v[108:111], v1, s[40:43], s61 offen offset:256 nt
    buffer_load_dwordx4 v[112:115], v1, s[36:39], s62 offen offset:0 nt
    buffer_load_dwordx4 v[116:119], v1, s[36:39], s62 offen offset:128 nt
    buffer_load_dwordx4 v[120:123], v1, s[36:39], s62 offen offset:256 nt
    buffer_load_dwordx4 v[124:127], v1, s[40:43], s62 offen offset:0 nt
    buffer_load_dwordx4 v[128:131], v1, s[40:43], s62 offen offset:128 nt
    buffer_load_dwordx4 v[132:135], v1, s[40:43], s62 offen offset:256 nt
    v_mov_b32 v10, 1152
    v_mov_b32 v11, 1
    s_mov_b64 exec, 1
    ds_add_rtn_u32 v51, v10, v11
    s_mov_b64 exec, -1
    v_and_b32 v5, 7, v0
    v_lshrrev_b32 v4, 1, v5
    v_and_b32 v5, 1, v5
    v_mov_b32 v6, 0xffff
    v_mov_b32 v8, 0xffff0000
    v_cmp_eq_u32 vcc, 1, v5
    v_mov_b32 v2, 0
    v_mov_b32 v3, 0
    v_cndmask_b32 v6, v6, v8, vcc
    v_cmp_eq_u32 vcc, 0, v4
    s_nop 1
    v_cndmask_b32 v36, v3, v6, vcc
    v_cmp_eq_u32 vcc, 1, v4
    s_nop 1
    v_cndmask_b32 v37, v3, v6, vcc
    v_cmp_eq_u32 vcc, 2, v4
    s_nop 1
    v_cndmask_b32 v38, v3, v6, vcc
    v_cmp_eq_u32 vcc, 3, v4
    s_nop 1
    v_cndmask_b32 v39, v3, v6, vcc
    v_mov_b32 v24, 0
    v_mov_b32 v25, 0
    v_mov_b32 v26, 0
    v_mov_b32 v27, 0
    v_mov_b32 v28, 0
    v_mov_b32 v29, 0
    v_mov_b32 v30, 0
    v_mov_b32 v31, 0
    v_mov_b32 v32, 0
    v_mov_b32 v33, 0
    v_mov_b32 v34, 0
    v_mov_b32 v35, 0
    v_mov_b32 v4, 0xff61b1e6
    v_mov_b32 v5, 0
    s_cmp_lg_u32 s15, 0
    s_cbranch_scc1 L_notree1
    s_waitcnt vmcnt(18)
    v_dot2_f32_bf16 v4, v52, v12, 0
    s_nop 2
    v_dot2c_f32_bf16 v4, v53, v13
    v_dot2c_f32_bf16 v4, v54, v14
    v_dot2c_f32_bf16 v4, v55, v15
    v_dot2c_f32_bf16 v4, v56, v16
    v_dot2c_f32_bf16 v4, v57, v17
    v_dot2c_f32_bf16 v4, v58, v18
    v_dot2c_f32_bf16 v4, v59, v19
    v_dot2c_f32_bf16 v4, v60, v20
    v_dot2c_f32_bf16 v4, v61, v21
    v_dot2c_f32_bf16 v4, v62, v22
    v_dot2c_f32_bf16 v4, v63, v23
    s_nop 2
    v_add_f32_dpp v4, v4, v4 quad_perm:[1,0,3,2] row_mask:0xf bank_mask:0xf
    s_nop 1
    v_add_f32_dpp v4, v4, v4 quad_perm:[2,3,0,1] row_mask:0xf bank_mask:0xf
    s_nop 1
    v_add_f32_dpp v4, v4, v4 row_half_mirror row_mask:0xf bank_mask:0xf
    s_nop 1
    v_lshlrev_b32 v9, 16, v9
    v_sub_f32 v9, 1.0, v9
    v_mov_b32 v6, 0xd04e79ff
    v_fma_f32 v4, v9, v6, v4
    s_mov_b32 exec_lo, 0xff
    s_mov_b32 exec_hi, 0
    v_mov_b32 v5, 1.0
    s_mov_b32 exec_lo, 0x00ff00ff
    v_lshlrev_b32 v24, 16, v40
    v_and_b32 v25, 0xffff0000, v40
    v_lshlrev_b32 v26, 16, v41
    v_and_b32 v27, 0xffff0000, v41
    v_lshlrev_b32 v28, 16, v42
    v_and_b32 v29, 0xffff0000, v42
    v_lshlrev_b32 v30, 16, v43
    v_and_b32 v31, 0xffff0000, v43
    v_lshlrev_b32 v32, 16, v44
    v_and_b32 v33, 0xffff0000, v44
    v_lshlrev_b32 v34, 16, v45
    v_and_b32 v35, 0xffff0000, v45
    s_mov_b64 exec, -1
L_notree1:
L_loop:
    s_cmp_eq_u32 s60, 1073741824
    s_cbranch_scc1 L_done
    s_waitcnt vmcnt(15)
    v_dot2_f32_bf16 v48, v64, v12, 0
    s_nop 2
    v_dot2c_f32_bf16 v48, v65, v13
    v_dot2c_f32_bf16 v48, v66, v14
    v_dot2c_f32_bf16 v48, v67, v15
    v_dot2c_f32_bf16 v48, v68, v16
    v_dot2c_f32_bf16 v48, v69, v17
    v_dot2c_f32_bf16 v48, v70, v18
    v_dot2c_f32_bf16 v48, v71, v19
    v_dot2c_f32_bf16 v48, v72, v20
    v_dot2c_f32_bf16 v48, v73, v21
    v_dot2c_f32_bf16 v48, v74, v22
    v_dot2c_f32_bf16 v48, v75, v23
    s_waitcnt lgkmcnt(0)
    v_readfirstlane_b32 s13, v51
    s_mov_b64 exec, 1
    ds_add_rtn_u32 v51, v10, v11
    s_mov_b64 exec, -1
    s_mul_i32 s14, s13, 3072
    s_cmp_lt_u32 s13, 128
    s_cselect_b32 s60, s14, 1073741824
    buffer_load_dwordx4 v[64:67], v1, s[36:39], s60 offen offset:0 nt
    buffer_load_dwordx4 v[68:71], v1, s[36:39], s60 offen offset:128 nt
    buffer_load_dwordx4 v[72:75], v1, s[36:39], s60 offen offset:256 nt
    v_add_f32_dpp v48, v48, v48 quad_perm:[1,0,3,2] row_mask:0xf bank_mask:0xf
    s_nop 1
    v_add_f32_dpp v48, v48, v48 quad_perm:[2,3,0,1] row_mask:0xf bank_mask:0xf
    s_nop 1
    v_add_f32_dpp v48, v48, v48 row_half_mirror row_mask:0xf bank_mask:0xf
    s_nop 1
    v_cmp_gt_f32 vcc, v48, v4
    s_cbranch_vccnz L_resc0
L_back0:
    v_mul_f32 v7, s10, v4
    v_fma_f32 v48, v48, s10, -v7
    v_exp_f32 v48, v48
    s_nop 0
    v_add_f32 v5, v5, v48
    v_cvt_pk_bf16_f32 v48, v48, v48
    v_and_b32 v40, v48, v36
    v_and_b32 v41, v48, v37
    v_and_b32 v42, v48, v38
    v_and_b32 v43, v48, v39
    s_waitcnt vmcnt(15)
    s_nop 0
    v_mfma_f32_16x16x32_bf16 v[24:27], v[40:43], v[76:79], v[24:27]
    v_mfma_f32_16x16x32_bf16 v[28:31], v[40:43], v[80:83], v[28:31]
    v_mfma_f32_16x16x32_bf16 v[32:35], v[40:43], v[84:87], v[32:35]
    buffer_load_dwordx4 v[76:79], v1, s[40:43], s60 offen offset:0 nt
    buffer_load_dwordx4 v[80:83], v1, s[40:43], s60 offen offset:128 nt
    buffer_load_dwordx4 v[84:87], v1, s[40:43], s60 offen offset:256 nt
    s_cmp_eq_u32 s61, 1073741824
    s_cbranch_scc1 L_done
    s_waitcnt vmcnt(15)
    v_dot2_f32_bf16 v48, v88, v12, 0
    s_nop 2
    v_dot2c_f32_bf16 v48, v89, v13
    v_dot2c_f32_bf16 v48, v90, v14
    v_dot2c_f32_bf16 v48, v91, v15
    v_dot2c_f32_bf16 v48, v92, v16
    v_dot2c_f32_bf16 v48, v93, v17
    v_dot2c_f32_bf16 v48, v94, v18
    v_dot2c_f32_bf16 v48, v95, v19
    v_dot2c_f32_bf16 v48, v96, v20
    v_dot2c_f32_bf16 v48, v97, v21
    v_dot2c_f32_bf16 v48, v98, v22
    v_dot2c_f32_bf16 v48, v99, v23
    s_waitcnt lgkmcnt(0)
    v_readfirstlane_b32 s13, v51
    s_mov_b64 exec, 1
    ds_add_rtn_u32 v51, v10, v11
    s_mov_b64 exec, -1
    s_mul_i32 s14, s13, 3072
    s_cmp_lt_u32 s13, 128
    s_cselect_b32 s61, s14, 1073741824
    buffer_load_dwordx4 v[88:91], v1, s[36:39], s61 offen offset:0 nt
    buffer_load_dwordx4 v[92:95], v1, s[36:39], s61 offen offset:128 nt
    buffer_load_dwordx4 v[96:99], v1, s[36:39], s61 offen offset:256 nt
    v_add_f32_dpp v48, v48, v48 quad_perm:[1,0,3,2] row_mask:0xf bank_mask:0xf
    s_nop 1
    v_add_f32_dpp v48, v48, v48 quad_perm:[2,3,0,1] row_mask:0xf bank_mask:0xf
    s_nop 1
    v_add_f32_dpp v48, v48, v48 row_half_mirror row_mask:0xf bank_mask:0xf
    s_nop 1
    v_cmp_gt_f32 vcc, v48, v4
    s_cbranch_vccnz L_resc1
L_back1:
    v_mul_f32 v7, s10, v4
    v_fma_f32 v48, v48, s10, -v7
    v_exp_f32 v48, v48
    s_nop 0
    v_add_f32 v5, v5, v48
    v_cvt_pk_bf16_f32 v48, v48, v48
    v_and_b32 v40, v48, v36
    v_and_b32 v41, v48, v37
    v_and_b32 v42, v48, v38
    v_and_b32 v43, v48, v39
    s_waitcnt vmcnt(15)
    s_nop 0
    v_mfma_f32_16x16x32_bf16 v[24:27], v[40:43], v[100:103], v[24:27]
    v_mfma_f32_16x16x32_bf16 v[28:31], v[40:43], v[104:107], v[28:31]
    v_mfma_f32_16x16x32_bf16 v[32:35], v[40:43], v[108:111], v[32:35]
    buffer_load_dwordx4 v[100:103], v1, s[40:43], s61 offen offset:0 nt
    buffer_load_dwordx4 v[104:107], v1, s[40:43], s61 offen offset:128 nt
    buffer_load_dwordx4 v[108:111], v1, s[40:43], s61 offen offset:256 nt
    s_cmp_eq_u32 s62, 1073741824
    s_cbranch_scc1 L_done
    s_waitcnt vmcnt(15)
    v_dot2_f32_bf16 v48, v112, v12, 0
    s_nop 2
    v_dot2c_f32_bf16 v48, v113, v13
    v_dot2c_f32_bf16 v48, v114, v14
    v_dot2c_f32_bf16 v48, v115, v15
    v_dot2c_f32_bf16 v48, v116, v16
    v_dot2c_f32_bf16 v48, v117, v17
    v_dot2c_f32_bf16 v48, v118, v18
    v_dot2c_f32_bf16 v48, v119, v19
    v_dot2c_f32_bf16 v48, v120, v20
    v_dot2c_f32_bf16 v48, v121, v21
    v_dot2c_f32_bf16 v48, v122, v22
    v_dot2c_f32_bf16 v48, v123, v23
    s_waitcnt lgkmcnt(0)
    v_readfirstlane_b32 s13, v51
    s_mov_b64 exec, 1
    ds_add_rtn_u32 v51, v10, v11
    s_mov_b64 exec, -1
    s_mul_i32 s14, s13, 3072
    s_cmp_lt_u32 s13, 128
    s_cselect_b32 s62, s14, 1073741824
    buffer_load_dwordx4 v[112:115], v1, s[36:39], s62 offen offset:0 nt
    buffer_load_dwordx4 v[116:119], v1, s[36:39], s62 offen offset:128 nt
    buffer_load_dwordx4 v[120:123], v1, s[36:39], s62 offen offset:256 nt
    v_add_f32_dpp v48, v48, v48 quad_perm:[1,0,3,2] row_mask:0xf bank_mask:0xf
    s_nop 1
    v_add_f32_dpp v48, v48, v48 quad_perm:[2,3,0,1] row_mask:0xf bank_mask:0xf
    s_nop 1
    v_add_f32_dpp v48, v48, v48 row_half_mirror row_mask:0xf bank_mask:0xf
    s_nop 1
    v_cmp_gt_f32 vcc, v48, v4
    s_cbranch_vccnz L_resc2
L_back2:
    v_mul_f32 v7, s10, v4
    v_fma_f32 v48, v48, s10, -v7
    v_exp_f32 v48, v48
    s_nop 0
    v_add_f32 v5, v5, v48
    v_cvt_pk_bf16_f32 v48, v48, v48
    v_and_b32 v40, v48, v36
    v_and_b32 v41, v48, v37
    v_and_b32 v42, v48, v38
    v_and_b32 v43, v48, v39
    s_waitcnt vmcnt(15)
    s_nop 0
    v_mfma_f32_16x16x32_bf16 v[24:27], v[40:43], v[124:127], v[24:27]
    v_mfma_f32_16x16x32_bf16 v[28:31], v[40:43], v[128:131], v[28:31]
    v_mfma_f32_16x16x32_bf16 v[32:35], v[40:43], v[132:135], v[32:35]
    buffer_load_dwordx4 v[124:127], v1, s[40:43], s62 offen offset:0 nt
    buffer_load_dwordx4 v[128:131], v1, s[40:43], s62 offen offset:128 nt
    buffer_load_dwordx4 v[132:135], v1, s[40:43], s62 offen offset:256 nt
    s_branch L_loop
L_resc0:
    v_max_f32 v6, v48, v4
    s_nop 1
    v_max_f32_dpp v6, v6, v6 row_ror:8 row_mask:0xf bank_mask:0xf
    s_nop 1
    v_max_f32_dpp v6, v6, v6 row_bcast:15 row_mask:0xa bank_mask:0xf
    s_nop 1
    v_max_f32_dpp v6, v6, v6 row_bcast:31 row_mask:0xc bank_mask:0xf
    s_nop 1
    v_readlane_b32 s11, v6, 63
    s_nop 1
    v_subrev_f32 v7, s11, v4
    v_mul_f32 v7, s10, v7
    v_exp_f32 v7, v7
    v_mov_b32 v4, s11
    s_nop 0
    v_mul_f32 v5, v5, v7
    v_mul_f32 v24, v24, v7
    v_mul_f32 v25, v25, v7
    v_mul_f32 v26, v26, v7
    v_mul_f32 v27, v27, v7
    v_mul_f32 v28, v28, v7
    v_mul_f32 v29, v29, v7
    v_mul_f32 v30, v30, v7
    v_mul_f32 v31, v31, v7
    v_mul_f32 v32, v32, v7
    v_mul_f32 v33, v33, v7
    v_mul_f32 v34, v34, v7
    v_mul_f32 v35, v35, v7
    s_nop 1
    s_branch L_back0
L_resc1:
    v_max_f32 v6, v48, v4
    s_nop 1
    v_max_f32_dpp v6, v6, v6 row_ror:8 row_mask:0xf bank_mask:0xf
    s_nop 1
    v_max_f32_dpp v6, v6, v6 row_bcast:15 row_mask:0xa bank_mask:0xf
    s_nop 1
    v_max_f32_dpp v6, v6, v6 row_bcast:31 row_mask:0xc bank_mask:0xf
    s_nop 1
    v_readlane_b32 s11, v6, 63
    s_nop 1
    v_subrev_f32 v7, s11, v4
    v_mul_f32 v7, s10, v7
    v_exp_f32 v7, v7
    v_mov_b32 v4, s11
    s_nop 0
    v_mul_f32 v5, v5, v7
    v_mul_f32 v24, v24, v7
    v_mul_f32 v25, v25, v7
    v_mul_f32 v26, v26, v7
    v_mul_f32 v27, v27, v7
    v_mul_f32 v28, v28, v7
    v_mul_f32 v29, v29, v7
    v_mul_f32 v30, v30, v7
    v_mul_f32 v31, v31, v7
    v_mul_f32 v32, v32, v7
    v_mul_f32 v33, v33, v7
    v_mul_f32 v34, v34, v7
    v_mul_f32 v35, v35, v7
    s_nop 1
    s_branch L_back1
L_resc2:
    v_max_f32 v6, v48, v4
    s_nop 1
    v_max_f32_dpp v6, v6, v6 row_ror:8 row_mask:0xf bank_mask:0xf
    s_nop 1
    v_max_f32_dpp v6, v6, v6 row_bcast:15 row_mask:0xa bank_mask:0xf
    s_nop 1
    v_max_f32_dpp v6, v6, v6 row_bcast:31 row_mask:0xc bank_mask:0xf
    s_nop 1
    v_readlane_b32 s11, v6, 63
    s_nop 1
    v_subrev_f32 v7, s11, v4
    v_mul_f32 v7, s10, v7
    v_exp_f32 v7, v7
    v_mov_b32 v4, s11
    s_nop 0
    v_mul_f32 v5, v5, v7
    v_mul_f32 v24, v24, v7
    v_mul_f32 v25, v25, v7
    v_mul_f32 v26, v26, v7
    v_mul_f32 v27, v27, v7
    v_mul_f32 v28, v28, v7
    v_mul_f32 v29, v29, v7
    v_mul_f32 v30, v30, v7
    v_mul_f32 v31, v31, v7
    v_mul_f32 v32, v32, v7
    v_mul_f32 v33, v33, v7
    v_mul_f32 v34, v34, v7
    v_mul_f32 v35, v35, v7
    s_nop 1
    s_branch L_back2
L_done:
    s_waitcnt vmcnt(0) lgkmcnt(0)
    v_mul_f32 v4, s10, v4
    v_add_f32_dpp v5, v5, v5 row_ror:8 row_mask:0xf bank_mask:0xf
    v_bfe_u32 v6, v0, 4, 1
    v_and_b32 v8, 7, v0
    v_add_f32_dpp v5, v5, v5 row_bcast:15 row_mask:0xa bank_mask:0xf
    v_lshlrev_b32 v6, 4, v6
    v_lshl_add_u32 v6, v8, 5, v6
    v_add_f32_dpp v5, v5, v5 row_bcast:31 row_mask:0xc bank_mask:0xf
    v_lshrrev_b32 v8, 5, v0
    s_movk_i32 s12, 768
    v_mad_u32_u24 v6, v8, s12, v6
    s_mul_i32 s12, s4, 1536
    s_add_u32 s12, s12, 2048
    v_add_u32 v6, s12, v6
    v_readlane_b32 s11, v5, 63
    s_lshl_b32 s12, s4, 3
    s_add_u32 s12, s12, 1024
    v_mov_b32 v8, s12
    v_mov_b32 v5, s11
    s_mov_b32 exec_lo, 0x00ff00ff
    s_mov_b32 exec_hi, 0xff00ff00
    ds_write_b128 v6, v[24:27] offset:0
    ds_write_b128 v6, v[28:31] offset:256
    ds_write_b128 v6, v[32:35] offset:512
    ds_write_b64 v8, v[4:5]
    s_mov_b64 exec, -1
    s_waitcnt lgkmcnt(0)
    s_barrier
    s_cmp_lg_u32 s4, 0
    s_cbranch_scc1 L_end
    v_and_b32 v6, 1, v0
    v_lshlrev_b32 v6, 3, v6
    v_lshlrev_b32 v8, 4, v0
    ds_read_b64 v[10:11], v6 offset:1024
    ds_read_b128 v[64:67], v8 offset:2048
    ds_read_b128 v[68:71], v8 offset:2816
    ds_read_b128 v[72:75], v8 offset:3584
    ds_read_b128 v[76:79], v8 offset:4352
    s_waitcnt lgkmcnt(4)
    v_mov_b32 v7, v10
    s_nop 1
    v_max_f32_dpp v7, v7, v7 quad_perm:[1,0,3,2] row_mask:0xf bank_mask:0xf
    v_sub_f32 v10, v10, v7
    v_exp_f32 v10, v10
    s_nop 0
    v_mul_f32 v16, v10, v11
    s_nop 1
    v_add_f32_dpp v16, v16, v16 quad_perm:[1,0,3,2] row_mask:0xf bank_mask:0xf
    v_readlane_b32 s64, v10, 0
    v_readlane_b32 s65, v10, 1
    s_nop 1
    s_waitcnt lgkmcnt(0)
    v_mul_f32 v12, s64, v64
    v_mul_f32 v13, s64, v65
    v_mul_f32 v14, s64, v66
    v_mul_f32 v15, s64, v67
    v_fma_f32 v12, s64, v68, v12
    v_fma_f32 v13, s64, v69, v13
    v_fma_f32 v14, s64, v70, v14
    v_fma_f32 v15, s64, v71, v15
    v_fma_f32 v12, s65, v72, v12
    v_fma_f32 v13, s65, v73, v13
    v_fma_f32 v14, s65, v74, v14
    v_fma_f32 v15, s65, v75, v15
    v_fma_f32 v12, s65, v76, v12
    v_fma_f32 v13, s65, v77, v13
    v_fma_f32 v14, s65, v78, v14
    v_fma_f32 v15, s65, v79, v15
    s_mov_b32 s36, s32
    s_mov_b32 s37, s33
    s_mov_b32 s38, 262144
    s_mov_b32 s40, s30
    s_mov_b32 s41, s31
    s_mov_b32 s42, 256
    s_mov_b32 s44, s28
    s_mov_b32 s45, s29
    s_lshl_b32 s12, s2, 10
    v_lshlrev_b32 v8, 4, v0
    v_add_u32 v8, s12, v8
    s_lshl_b32 s12, s5, 3
    v_mov_b32 v9, s12
    v_mov_b32 v17, 1
    s_waitcnt lgkmcnt(0)
    s_mov_b32 exec_lo, 0
    s_mov_b32 exec_hi, 0x10000
    v_mov_b32 v12, v7
    v_mov_b32 v13, v16
    s_mov_b32 exec_lo, -1
    s_mov_b32 exec_hi, 0x1ffff
    buffer_store_dwordx4 v[12:15], v8, s[36:39], 0 offen sc1
    s_waitcnt vmcnt(0)
    s_mov_b64 exec, 1
    buffer_atomic_add v17, v9, s[40:43], 0 offen sc0
    s_waitcnt vmcnt(0)
    v_readfirstlane_b32 s12, v17
    s_mov_b64 exec, -1
    s_cmp_lg_u32 s12, 7
    s_cbranch_scc1 L_end
    s_lshl_b32 s12, s5, 13
    v_lshlrev_b32 v8, 4, v0
    v_add_u32 v8, s12, v8
    v_and_b32 v9, 7, v0
    v_lshlrev_b32 v9, 10, v9
    v_add_u32 v9, s12, v9
    buffer_load_dwordx2 v[10:11], v9, s[36:39], 0 offen offset:768 sc1
    buffer_load_dwordx4 v[24:27], v8, s[36:39], 0 offen sc1
    s_mov_b32 s65, 1024
    buffer_load_dwordx4 v[28:31], v8, s[36:39], s65 offen sc1
    s_mov_b32 s66, 2048
    buffer_load_dwordx4 v[32:35], v8, s[36:39], s66 offen sc1
    s_mov_b32 s67, 3072
    buffer_load_dwordx4 v[36:39], v8, s[36:39], s67 offen sc1
    s_mov_b32 s68, 4096
    buffer_load_dwordx4 v[40:43], v8, s[36:39], s68 offen sc1
    s_mov_b32 s69, 5120
    buffer_load_dwordx4 v[44:47], v8, s[36:39], s69 offen sc1
    s_mov_b32 s70, 6144
    buffer_load_dwordx4 v[48:51], v8, s[36:39], s70 offen sc1
    s_mov_b32 s71, 7168
    buffer_load_dwordx4 v[52:55], v8, s[36:39], s71 offen sc1
    s_waitcnt vmcnt(8)
    v_mov_b32 v4, v10
    s_nop 1
    v_max_f32_dpp v4, v4, v4 quad_perm:[1,0,3,2] row_mask:0xf bank_mask:0xf
    s_nop 1
    v_max_f32_dpp v4, v4, v4 quad_perm:[2,3,0,1] row_mask:0xf bank_mask:0xf
    s_nop 1
    v_max_f32_dpp v4, v4, v4 row_half_mirror row_mask:0xf bank_mask:0xf
    v_sub_f32 v10, v10, v4
    v_exp_f32 v10, v10
    s_nop 0
    v_mul_f32 v11, v10, v11
    s_nop 1
    v_add_f32_dpp v11, v11, v11 quad_perm:[1,0,3,2] row_mask:0xf bank_mask:0xf
    s_nop 1
    v_add_f32_dpp v11, v11, v11 quad_perm:[2,3,0,1] row_mask:0xf bank_mask:0xf
    s_nop 1
    v_add_f32_dpp v11, v11, v11 row_half_mirror row_mask:0xf bank_mask:0xf
    v_rcp_f32 v11, v11
    s_nop 0
    v_mul_f32 v10, v10, v11
    s_nop 0
    v_readlane_b32 s64, v10, 0
    v_readlane_b32 s65, v10, 1
    v_readlane_b32 s66, v10, 2
    v_readlane_b32 s67, v10, 3
    v_readlane_b32 s68, v10, 4
    v_readlane_b32 s69, v10, 5
    v_readlane_b32 s70, v10, 6
    v_readlane_b32 s71, v10, 7
    s_waitcnt vmcnt(0)
    v_mul_f32 v12, s64, v24
    v_mul_f32 v13, s64, v25
    v_mul_f32 v14, s64, v26
    v_mul_f32 v15, s64, v27
    v_fma_f32 v12, s65, v28, v12
    v_fma_f32 v13, s65, v29, v13
    v_fma_f32 v14, s65, v30, v14
    v_fma_f32 v15, s65, v31, v15
    v_fma_f32 v12, s66, v32, v12
    v_fma_f32 v13, s66, v33, v13
    v_fma_f32 v14, s66, v34, v14
    v_fma_f32 v15, s66, v35, v15
    v_fma_f32 v12, s67, v36, v12
    v_fma_f32 v13, s67, v37, v13
    v_fma_f32 v14, s67, v38, v14
    v_fma_f32 v15, s67, v39, v15
    v_fma_f32 v12, s68, v40, v12
    v_fma_f32 v13, s68, v41, v13
    v_fma_f32 v14, s68, v42, v14
    v_fma_f32 v15, s68, v43, v15
    v_fma_f32 v12, s69, v44, v12
    v_fma_f32 v13, s69, v45, v13
    v_fma_f32 v14, s69, v46, v14
    v_fma_f32 v15, s69, v47, v15
    v_fma_f32 v12, s70, v48, v12
    v_fma_f32 v13, s70, v49, v13
    v_fma_f32 v14, s70, v50, v14
    v_fma_f32 v15, s70, v51, v15
    v_fma_f32 v12, s71, v52, v12
    v_fma_f32 v13, s71, v53, v13
    v_fma_f32 v14, s71, v54, v14
    v_fma_f32 v15, s71, v55, v15
    v_cvt_pk_bf16_f32 v12, v12, v13
    v_cvt_pk_bf16_f32 v13, v14, v15
    s_mul_i32 s12, s5, 384
    v_lshlrev_b32 v8, 3, v0
    v_add_u32 v8, s12, v8
    s_mov_b32 exec_lo, -1
    s_mov_b32 exec_hi, 0xffff
    buffer_store_dwordx2 v[12:13], v8, s[44:47], 0 offen sc1
L_end:
    s_endpgm
.section .rodata,"a"
.p2align 6
.amdhsa_kernel standalone__tree_speculative_verify_tree_attention_over_candidate_token_tree__decode_kernel
  .amdhsa_next_free_vgpr 136
  .amdhsa_next_free_sgpr 102
  .amdhsa_accum_offset 136
  .amdhsa_group_segment_fixed_size 0
  .amdhsa_kernarg_size 72
  .amdhsa_user_sgpr_count 2
  .amdhsa_user_sgpr_kernarg_segment_ptr 1
  .amdhsa_system_sgpr_workgroup_id_x 1
.end_amdhsa_kernel
```
